```python
import torch

def _softmax(x, axis=-1):
    return torch.softmax(x, dim=axis)
def _gelu(x):
    return torch.nn.functional.gelu(x, approximate="tanh")
def _silu(x):
    return torch.nn.functional.silu(x)
def _sigmoid(x):
    return torch.sigmoid(x)
def _layernorm(x, axis=-1, eps=1e-5):
    m = x.mean(dim=axis, keepdim=True)
    v = x.var(dim=axis, keepdim=True, unbiased=False)
    return (x - m) / torch.sqrt(v + eps)
def _scatter_add(tgt, idx, src, axis=0):
    return tgt.clone().index_add_(axis, idx, src)
def _segment_sum(src, seg, n):
    out = torch.zeros((n,) + src.shape[1:], dtype=src.dtype)
    return out.index_add_(0, seg, src)
def _pad(x, pw):
    flat = tuple(v for pair in reversed(pw) for v in pair)
    return torch.nn.functional.pad(x, flat)

kernel_name = 'standalone__sequential_behavior_din__recsys'

def setup_inputs():

    _w = (lambda a: (lambda t: t.to(torch.bfloat16) if t.is_floating_point() else t)(torch.as_tensor(a)))
    B, L, D = 4096, 200, 64
    H = D
    return {
        "target": _w((lambda *s: torch.randn(*s, dtype=torch.bfloat16) * 1.6)(B, D)),
        "hist": _w((lambda *s: torch.randn(*s, dtype=torch.bfloat16) * 1.6)(B, L, D)),
        "mask": _w((lambda lo, hi, *s: torch.randint(lo, hi, s))(0, 2, B, L).to(float)),
        "w1": _w((lambda *s: torch.randn(*s, dtype=torch.bfloat16) * 1.6)(4 * D, H) * (4 * D) ** -0.5),
        "b1": _w((lambda *s: torch.randn(*s, dtype=torch.bfloat16) * 1.6)(H) * 0.1),
        "w2": _w((lambda *s: torch.randn(*s, dtype=torch.bfloat16) * 0.05)(H, 1) * H ** -0.5),
        "b2": _w((lambda *s: torch.randn(*s, dtype=torch.bfloat16) * 0.05)(1) * 0.1),
    }

def reference(target, hist, mask, w1, b1, w2, b2):
    L = hist.shape[1]
    tgt = (lambda x, n, axis: torch.repeat_interleave(x, n, dim=axis))(target[:, None, :], L, axis=1)
    feat = torch.concatenate([hist, tgt, hist - tgt, hist * tgt], axis=-1)
    h = _sigmoid(feat @ w1 + b1)
    scores = (h @ w2 + b2)[..., 0] * mask
    return torch.einsum('bl,bld->bd', scores, hist)
```

```asm
; @launch grid=(256,1,1) block=(1024,1,1) lds=150272
.amdgcn_target "amdgcn-amd-amdhsa--gfx950"
.text
.globl standalone__sequential_behavior_din__recsys_kernel
.p2align 8
.type standalone__sequential_behavior_din__recsys_kernel,@function
standalone__sequential_behavior_din__recsys_kernel:
  s_cmp_ge_u32 s2, 256
  s_cbranch_scc1 L_end
  s_load_dwordx16 s[4:19], s[0:1], 0
  s_setprio 3
  v_lshrrev_b32 v76, 6, v0
  v_and_b32 v126, 63, v0
  s_lshl_b32 s21, s2, 4
  v_readfirstlane_b32 s20, v76
  v_mov_b32 v64, 0
  v_mov_b32 v65, 0
  s_add_u32 s21, s21, s20
  s_mul_i32 s74, s21, 400
  s_mul_i32 s56, s20, 7168
  v_lshl_add_u32 v82, v126, 3, s74
  v_and_b32 v78, 32, v126
  v_and_b32 v79, 31, v126
  s_lshl_b32 s75, s20, 9
  v_lshlrev_b32 v78, 9, v78
  s_add_u32 s71, s75, 23552
  v_lshl_add_u32 v83, v79, 4, s75
  v_lshl_add_u32 v84, v79, 4, s71
  s_bfm_b64 s[60:61], 50, 0
  v_add_u32 v83, v83, v78
  v_sub_u32 v84, v84, v78
  s_add_u32 s56, s56, 6656
  s_add_u32 m0, s56, 4096
  s_mov_b64 exec, s[60:61]
  s_waitcnt lgkmcnt(0)
  global_load_dwordx2 v[64:65], v82, s[8:9] nt
  s_mov_b64 exec, -1
  s_setprio 2
  global_load_lds_dwordx4 v83, s[10:11]
  global_load_lds_dwordx4 v84, s[10:11] offset:1024
  v_lshrrev_b32 v77, 4, v126
  s_sub_u32 s92, s20, 13
  s_cmp_gt_u32 s92, 2
  s_cbranch_scc1 L_nosmall
  s_cmp_eq_u32 s92, 1
  s_cbranch_scc1 L_w14
  s_cmp_eq_u32 s92, 2
  s_cbranch_scc1 L_w15
  v_mov_b32 v24, 0
  v_lshlrev_b32 v26, 1, v126
  global_load_short_d16_hi v24, v26, s[12:13]
  s_branch L_nosmall
L_w14:
  s_lshl_b32 s75, s2, 11
  v_lshl_add_u32 v26, v126, 4, s75
  s_mov_b32 m0, 512
  s_nop 0
  global_load_lds_dwordx4 v26, s[4:5]
  global_load_lds_dwordx4 v26, s[4:5] offset:1024
  s_branch L_nosmall
L_w15:
  v_bfe_u32 v26, v126, 4, 1
  v_lshlrev_b32 v26, 6, v26
  v_bfe_u32 v27, v126, 1, 1
  v_lshl_add_u32 v26, v27, 5, v26
  v_bfe_u32 v27, v126, 2, 2
  v_lshl_add_u32 v26, v27, 3, v26
  v_and_b32 v27, 1, v126
  v_lshl_add_u32 v26, v27, 2, v26
  v_mov_b32 v25, 0
  v_mov_b32 v27, 0
  s_mov_b32 m0, 256
  global_load_short_d16_hi v25, v27, s[16:17]
  s_bfm_b64 exec, 32, 0
  global_load_lds_dword v26, s[14:15]
  s_mov_b64 exec, -1
L_nosmall:
  s_lshl_b32 s57, s20, 8
  s_add_u32 s57, s57, 2560
  v_mov_b32 v0, -1
  v_lshl_add_u32 v79, v126, 2, s57
  ds_write_b32 v79, v0
  s_mul_i32 s74, s21, 25600
  v_and_b32 v78, 7, v126
  s_add_u32 s24, s6, s74
  v_xor_b32 v78, v78, v77
  s_addc_u32 s25, s7, 0
  v_lshlrev_b32 v121, 4, v78
  s_or_b32 s25, s25, 8388608
  v_xor_b32 v123, 64, v121
  s_mov_b32 s26, 200
  v_lshrrev_b32 v78, 3, v126
  s_mov_b32 s27, 0x20000
  v_add_u32 v124, s57, v78
  v_lshlrev_b32 v87, 2, v126
  s_mov_b32 s69, 0xffff
  v_add_u32 v88, 1, v87
  v_add_u32 v89, 2, v87
  v_add_u32 v90, 3, v87
  s_setprio 1
  v_and_b32 v76, 15, v126
  s_mov_b32 s70, 0xffff0000
  v_lshrrev_b32 v78, 1, v76
  s_mov_b32 s72, 0xbfb8aa3b
  v_xor_b32 v78, v78, v77
  s_mov_b32 s73, 0xbfb8aa3b
  v_lshlrev_b32 v78, 4, v78
  s_lshr_b32 s88, s20, 3
  v_lshl_add_u32 v78, v76, 7, v78
  s_and_b32 s89, s20, 1
  v_add_u32 v114, s56, v78
  s_bfe_u32 s90, s20, 0x20001
  v_xor_b32 v115, 64, v114
  s_lshl_b32 s74, s88, 11
  v_lshrrev_b32 v78, 2, v76
  s_lshl_b32 s71, s89, 10
  v_and_b32 v51, 3, v126
  s_add_u32 s74, s74, s71
  v_cmp_eq_u32_e64 s[62:63], v78, v77
  s_lshl_b32 s71, s90, 8
  v_lshlrev_b32 v51, 3, v51
  s_add_u32 s74, s74, s71
  v_lshl_add_u32 v51, v78, 7, v51
  s_add_u32 s74, s74, 121344
  v_lshl_add_u32 v51, v77, 5, v51
  s_lshl_b32 s88, s88, 10
  v_lshl_add_u32 v78, v77, 2, v78
  s_add_u32 s88, s88, s71
  v_lshrrev_b32 v79, 1, v78
  s_lshl_b32 s89, s89, 3
  v_bfe_u32 v80, v126, 1, 1
  s_add_u32 s88, s88, s89
  v_xor_b32 v79, v79, v80
  s_add_u32 s88, s88, 137728
  v_lshlrev_b32 v79, 4, v79
  s_add_u32 s71, s56, 4096
  v_lshl_add_u32 v79, v78, 7, v79
  s_lshl_b32 s90, s20, 7
  v_and_b32 v78, 1, v126
  s_add_u32 s90, s90, 512
  v_lshl_add_u32 v79, v78, 3, v79
  v_lshlrev_b32 v127, 4, v77
  v_add_u32 v116, s56, v79
  v_lshlrev_b32 v76, 4, v76
  v_xor_b32 v117, 32, v116
  v_xor_b32 v118, 64, v116
  v_xor_b32 v119, 96, v116
  v_lshl_add_u32 v48, v77, 12, v76
  v_lshl_add_u32 v50, v77, 11, v76
  v_add_u32 v51, s71, v51
  v_add_u32 v48, s74, v48
  v_add_u32 v50, s88, v50
  v_add_u32 v85, s90, v127
  v_lshlrev_b32 v108, 4, v126
  v_add_u32 v91, 137728, v108
  v_add_u32 v108, 121344, v108
  v_lshlrev_b32 v78, 4, v78
  v_mov_b32 v79, 0xffff
  v_lshlrev_b32 v79, v78, v79
  v_cmp_gt_u32 vcc, 32, v126
  v_cndmask_b32_e64 v79, 0, v79, s[62:63]
  v_cmp_eq_u32_e64 s[62:63], 0, v80
  v_mov_b32 v76, 0x3f80
  v_mov_b32 v78, s57
  v_cndmask_b32 v112, 0, v76, vcc
  v_mov_b32 v113, 0
  v_cndmask_b32_e64 v110, 0, v79, s[62:63]
  v_cndmask_b32_e64 v111, v79, 0, s[62:63]
  s_mov_b32 s74, 0x3f803f80
  v_and_b32 v96, s74, v110
  v_and_b32 v97, s74, v111
  s_waitcnt vmcnt(2)
  s_setprio 3
  v_cmp_ne_u16_e64 s[60:61], 0, v64
  v_cmp_lt_u32_e64 s[62:63], s69, v64
  v_cmp_ne_u16_e64 s[64:65], 0, v65
  v_cmp_lt_u32_e64 s[66:67], s69, v65
  v_mbcnt_lo_u32_b32 v78, s60, v78
  v_mbcnt_hi_u32_b32 v78, s61, v78
  v_mbcnt_lo_u32_b32 v78, s62, v78
  v_mbcnt_hi_u32_b32 v78, s63, v78
  v_mbcnt_lo_u32_b32 v78, s64, v78
  v_mbcnt_hi_u32_b32 v78, s65, v78
  v_mbcnt_lo_u32_b32 v78, s66, v78
  v_mbcnt_hi_u32_b32 v78, s67, v78
  s_mov_b64 exec, s[60:61]
  ds_write_b8 v78, v87
  s_mov_b64 exec, -1
  v_addc_co_u32_e64 v79, s[78:79], 0, v78, s[60:61]
  v_addc_co_u32_e64 v80, s[78:79], 0, v79, s[62:63]
  v_addc_co_u32_e64 v81, s[78:79], 0, v80, s[64:65]
  s_mov_b64 exec, s[62:63]
  ds_write_b8 v79, v88
  s_mov_b64 exec, s[64:65]
  ds_write_b8 v80, v89
  s_mov_b64 exec, s[66:67]
  ds_write_b8 v81, v90
  s_mov_b64 exec, -1
  ds_read_u8 v120, v124
  ds_read_u8 v122, v124 offset:8
  s_bcnt1_i32_b64 s58, s[60:61]
  s_bcnt1_i32_b64 s71, s[62:63]
  s_add_u32 s58, s58, s71
  s_bcnt1_i32_b64 s71, s[64:65]
  s_add_u32 s58, s58, s71
  s_bcnt1_i32_b64 s71, s[66:67]
  s_add_u32 s58, s58, s71
  s_waitcnt lgkmcnt(1)
  s_add_u32 m0, s56, 0
  s_nop 0
  buffer_load_dwordx4 v[120:121], s[24:27], 0 idxen offen nt lds
  s_waitcnt lgkmcnt(0)
  s_add_u32 m0, s56, 1024
  s_nop 0
  buffer_load_dwordx4 v[122:123], s[24:27], 0 idxen offen nt lds
  s_setprio 2
  s_waitcnt vmcnt(2)
  ds_read_b64_tr_b16 v[16:17], v51 offset:0
  ds_read_b64_tr_b16 v[18:19], v51 offset:512
  ds_read_b64_tr_b16 v[20:21], v51 offset:1024
  ds_read_b64_tr_b16 v[22:23], v51 offset:1536
  ds_read_u8 v120, v124 offset:16
  ds_read_u8 v122, v124 offset:24
  s_add_u32 s59, s58, 15
  s_lshr_b32 s59, s59, 4
  s_movk_i32 s74, 0x3f80
  v_cmp_eq_u16_e64 s[88:89], s74, v64
  v_cmp_eq_u16_e64 s[92:93], s74, v65
  v_cmp_eq_u16_sdwa s[90:91], v64, s74 src0_sel:WORD_1 src1_sel:WORD_0
  v_cmp_eq_u16_sdwa s[94:95], v65, s74 src0_sel:WORD_1 src1_sel:WORD_0
  s_xor_b64 s[76:77], s[88:89], s[60:61]
  s_xor_b64 s[92:93], s[92:93], s[64:65]
  s_or_b64 s[76:77], s[76:77], s[92:93]
  s_xor_b64 s[90:91], s[90:91], s[62:63]
  s_or_b64 s[76:77], s[76:77], s[90:91]
  s_xor_b64 s[94:95], s[94:95], s[66:67]
  s_or_b64 s[76:77], s[76:77], s[94:95]
  s_cmp_lg_u64 s[76:77], 0
  s_cbranch_scc1 L_genmask
L_binmask:
  s_waitcnt lgkmcnt(0)
  v_lshlrev_b32 v0, 16, v16
  v_and_b32 v1, s70, v16
  v_lshlrev_b32 v2, 16, v17
  v_and_b32 v3, s70, v17
  v_lshlrev_b32 v4, 16, v18
  v_and_b32 v5, s70, v18
  v_lshlrev_b32 v6, 16, v19
  v_and_b32 v7, s70, v19
  v_lshlrev_b32 v8, 16, v20
  v_and_b32 v9, s70, v20
  v_lshlrev_b32 v10, 16, v21
  v_and_b32 v11, s70, v21
  v_lshlrev_b32 v12, 16, v22
  v_and_b32 v13, s70, v22
  v_lshlrev_b32 v14, 16, v23
  v_and_b32 v15, s70, v23
  v_pk_add_f32 v[0:1], v[0:1], v[4:5]
  v_pk_add_f32 v[2:3], v[2:3], v[6:7]
  v_pk_add_f32 v[12:13], v[12:13], v[4:5] neg_lo:[0,1] neg_hi:[0,1]
  v_pk_add_f32 v[14:15], v[14:15], v[6:7] neg_lo:[0,1] neg_hi:[0,1]
  v_pk_mul_f32 v[0:1], v[0:1], s[72:73]
  v_pk_mul_f32 v[2:3], v[2:3], s[72:73]
  v_pk_mul_f32 v[8:9], v[8:9], s[72:73]
  v_pk_mul_f32 v[10:11], v[10:11], s[72:73]
  v_pk_mul_f32 v[12:13], v[12:13], s[72:73]
  v_pk_mul_f32 v[14:15], v[14:15], s[72:73]
  v_cvt_pk_bf16_f32 v18, v8, v9
  v_cvt_pk_bf16_f32 v19, v10, v11
  v_cvt_pk_bf16_f32 v16, v0, v1
  v_cvt_pk_bf16_f32 v17, v2, v3
  v_cvt_pk_bf16_f32 v22, v12, v13
  v_cvt_pk_bf16_f32 v23, v14, v15
  ds_write_b128 v48, v[16:19]
  ds_write_b64 v50, v[22:23]
  s_cmp_eq_u32 s20, 13
  s_cbranch_scc0 L_nb1
  v_mul_f32 v24, s72, v24
  v_lshlrev_b32 v26, 2, v126
  ds_write_b32 v26, v24 offset:0
L_nb1:
  s_cmp_eq_u32 s20, 15
  s_cbranch_scc0 L_nosmall2
  v_and_b32 v26, 15, v126
  v_lshlrev_b32 v26, 2, v26
  ds_write_b32 v26, v25 offset:384
  v_mov_b32 v26, 0
  ds_write_b32 v26, v26 offset:448
L_nosmall2:
  s_waitcnt lgkmcnt(0)
  s_barrier
  s_setprio 3
  ds_read_b128 v[100:103], v85
  ds_read_b128 v[104:107], v85 offset:64
  s_sub_u32 s92, s20, 4
  s_cmp_lt_u32 s92, 4
  s_cbranch_scc0 L_noc
  v_and_b32 v0, 15, v126
  s_lshl_b32 s74, s92, 11
  v_lshl_add_u32 v1, v0, 7, v127
  v_add_u32 v2, s74, v91
  s_lshl_b32 s74, s92, 6
  v_add_u32 v3, s74, v127
  ds_read_b128 v[4:7], v1 offset:512
  ds_read_b128 v[8:11], v1 offset:576
  ds_read_b128 v[12:15], v2
  ds_read_b128 v[16:19], v2 offset:1024
  ds_read_b128 v[20:23], v3 offset:0
  v_mul_u32_u24 v0, 272, v0
  v_add_u32 v0, v0, v3
  v_add_u32 v0, 145920, v0
  v_mov_b32 v1, 1
  v_mov_b32 v2, 0
  s_waitcnt lgkmcnt(0)
  v_mfma_f32_16x16x32_bf16 v[20:23], v[12:15], v[4:7], v[20:23]
  v_mfma_f32_16x16x32_bf16 v[20:23], v[16:19], v[8:11], v[20:23]
  s_nop 7
  ds_write_b128 v0, v[20:23]
  s_waitcnt lgkmcnt(0)
  s_mov_b64 exec, 1
  ds_add_u32 v2, v1 offset:448
  s_mov_b64 exec, -1
L_noc:
  s_cmp_lt_u32 s20, 8
  s_cbranch_scc1 L_rd1
  s_add_u32 m0, s56, 2048
  s_nop 0
  buffer_load_dwordx4 v[120:121], s[24:27], 0 idxen offen nt lds
  s_add_u32 m0, s56, 3072
  s_nop 0
  buffer_load_dwordx4 v[122:123], s[24:27], 0 idxen offen nt lds
L_rd1:
  s_cmp_lt_u32 s20, 8
  s_cbranch_scc1 L_rd2
  ds_read_u8 v120, v124 offset:32
  ds_read_u8 v122, v124 offset:40
L_rd2:
  ds_read_b128 v[48:51], v108 offset:0
  ds_read_b128 v[52:55], v108 offset:4096
  ds_read_b128 v[56:59], v108 offset:8192
  ds_read_b128 v[60:63], v108 offset:12288
  s_waitcnt lgkmcnt(4)
  v_and_b32 v98, v100, v110
  v_and_b32 v99, v101, v111
  ds_read_b128 v[64:67], v108 offset:1024
  ds_read_b128 v[68:71], v108 offset:5120
  ds_read_b128 v[72:75], v108 offset:9216
  ds_read_b128 v[92:95], v108 offset:13312
  s_waitcnt lgkmcnt(4)
  v_mfma_f32_16x16x32_bf16 v[76:79], v[96:99], v[48:51], 0
  v_mfma_f32_16x16x32_bf16 v[80:83], v[96:99], v[52:55], 0
  v_mfma_f32_16x16x32_bf16 v[84:87], v[96:99], v[56:59], 0
  v_mfma_f32_16x16x32_bf16 v[88:91], v[96:99], v[60:63], 0
  v_and_b32 v98, v102, v110
  v_and_b32 v99, v103, v111
  s_nop 2
  v_cvt_pk_bf16_f32 v0, v76, v77
  v_cvt_pk_bf16_f32 v1, v78, v79
  v_cvt_pk_bf16_f32 v8, v80, v81
  v_cvt_pk_bf16_f32 v9, v82, v83
  v_cvt_pk_bf16_f32 v16, v84, v85
  v_cvt_pk_bf16_f32 v17, v86, v87
  v_cvt_pk_bf16_f32 v24, v88, v89
  v_cvt_pk_bf16_f32 v25, v90, v91
  s_cmp_lt_u32 s20, 8
  s_cbranch_scc0 L_rd3
  s_add_u32 m0, s56, 2048
  s_nop 0
  buffer_load_dwordx4 v[120:121], s[24:27], 0 idxen offen nt lds
  s_add_u32 m0, s56, 3072
  s_nop 0
  buffer_load_dwordx4 v[122:123], s[24:27], 0 idxen offen nt lds
  ds_read_u8 v120, v124 offset:32
  ds_read_u8 v122, v124 offset:40
L_rd3:
  ds_read_b128 v[48:51], v108 offset:2048
  ds_read_b128 v[52:55], v108 offset:6144
  ds_read_b128 v[56:59], v108 offset:10240
  ds_read_b128 v[60:63], v108 offset:14336
  s_waitcnt lgkmcnt(4)
  v_mfma_f32_16x16x32_bf16 v[76:79], v[96:99], v[64:67], 0
  v_mfma_f32_16x16x32_bf16 v[80:83], v[96:99], v[68:71], 0
  v_mfma_f32_16x16x32_bf16 v[84:87], v[96:99], v[72:75], 0
  v_mfma_f32_16x16x32_bf16 v[88:91], v[96:99], v[92:95], 0
  v_and_b32 v98, v104, v110
  v_and_b32 v99, v105, v111
  s_nop 2
  v_cvt_pk_bf16_f32 v2, v76, v77
  v_cvt_pk_bf16_f32 v3, v78, v79
  v_cvt_pk_bf16_f32 v10, v80, v81
  v_cvt_pk_bf16_f32 v11, v82, v83
  v_cvt_pk_bf16_f32 v18, v84, v85
  v_cvt_pk_bf16_f32 v19, v86, v87
  v_cvt_pk_bf16_f32 v26, v88, v89
  v_cvt_pk_bf16_f32 v27, v90, v91
  s_cmp_lt_u32 s20, 8
  s_cbranch_scc1 L_rd4
  s_waitcnt lgkmcnt(0)
  s_add_u32 m0, s56, 4096
  s_nop 0
  buffer_load_dwordx4 v[120:121], s[24:27], 0 idxen offen nt lds
  s_add_u32 m0, s56, 5120
  s_nop 0
  buffer_load_dwordx4 v[122:123], s[24:27], 0 idxen offen nt lds
L_rd4:
  ds_read_b128 v[64:67], v108 offset:3072
  ds_read_b128 v[68:71], v108 offset:7168
  ds_read_b128 v[72:75], v108 offset:11264
  ds_read_b128 v[92:95], v108 offset:15360
  s_waitcnt lgkmcnt(4)
  v_mfma_f32_16x16x32_bf16 v[76:79], v[96:99], v[48:51], 0
  v_mfma_f32_16x16x32_bf16 v[80:83], v[96:99], v[52:55], 0
  v_mfma_f32_16x16x32_bf16 v[84:87], v[96:99], v[56:59], 0
  v_mfma_f32_16x16x32_bf16 v[88:91], v[96:99], v[60:63], 0
  v_and_b32 v98, v106, v110
  v_and_b32 v99, v107, v111
  s_nop 2
  v_cvt_pk_bf16_f32 v4, v76, v77
  v_cvt_pk_bf16_f32 v5, v78, v79
  v_cvt_pk_bf16_f32 v12, v80, v81
  v_cvt_pk_bf16_f32 v13, v82, v83
  v_cvt_pk_bf16_f32 v20, v84, v85
  v_cvt_pk_bf16_f32 v21, v86, v87
  v_cvt_pk_bf16_f32 v28, v88, v89
  v_cvt_pk_bf16_f32 v29, v90, v91
  s_cmp_lt_u32 s20, 8
  s_cbranch_scc0 L_rd5
  s_waitcnt lgkmcnt(0)
  s_add_u32 m0, s56, 4096
  s_nop 0
  buffer_load_dwordx4 v[120:121], s[24:27], 0 idxen offen nt lds
  s_add_u32 m0, s56, 5120
  s_nop 0
  buffer_load_dwordx4 v[122:123], s[24:27], 0 idxen offen nt lds
L_rd5:
  s_waitcnt lgkmcnt(0)
  v_mfma_f32_16x16x32_bf16 v[76:79], v[96:99], v[64:67], 0
  v_mfma_f32_16x16x32_bf16 v[80:83], v[96:99], v[68:71], 0
  v_mfma_f32_16x16x32_bf16 v[84:87], v[96:99], v[72:75], 0
  v_mfma_f32_16x16x32_bf16 v[88:91], v[96:99], v[92:95], 0
  v_mov_b32 v96, 0
  s_mul_i32 s75, s20, 272
  ds_read_b32 v97, v96 offset:448
  ds_read_b128 v[64:67], v127 offset:256
  ds_read_b128 v[68:71], v127 offset:320
  ds_read_b128 v[72:75], v127 offset:384
  s_add_u32 s75, s75, 145920
  v_add_u32 v98, s75, v127
  v_cvt_pk_bf16_f32 v6, v76, v77
  v_cvt_pk_bf16_f32 v7, v78, v79
  v_cvt_pk_bf16_f32 v14, v80, v81
  v_cvt_pk_bf16_f32 v15, v82, v83
  v_cvt_pk_bf16_f32 v22, v84, v85
  v_cvt_pk_bf16_f32 v23, v86, v87
  v_cvt_pk_bf16_f32 v30, v88, v89
  v_cvt_pk_bf16_f32 v31, v90, v91
  s_waitcnt lgkmcnt(3)
L_cpoll:
  v_readfirstlane_b32 s74, v97
  s_cmp_ge_u32 s74, 4
  s_cbranch_scc1 L_cready
  ds_read_b32 v97, v96 offset:448
  s_waitcnt lgkmcnt(0)
  s_branch L_cpoll
L_cready:
  ds_read_b128 v[32:35], v98 offset:0
  ds_read_b128 v[36:39], v98 offset:64
  ds_read_b128 v[40:43], v98 offset:128
  ds_read_b128 v[44:47], v98 offset:192
  s_mov_b32 s60, 0xffff0000
  s_mov_b32 s61, 0
  s_mov_b32 s62, 0
  s_mov_b32 s63, 0xffff
  s_mov_b32 s64, 0
  s_mov_b32 s65, 0xffff0000
  s_lshl_b32 s94, s21, 7
  s_lshr_b32 s42, s20, 2
  s_lshl_b32 s42, s42, 2
  s_lshr_b32 s40, 9029, s42
  s_lshr_b32 s41, 4386, s42
  s_and_b32 s40, s40, 15
  s_and_b32 s41, s41, 15
  v_mov_b32 v110, 0
  v_mov_b32 v111, 0
  v_add_u32 v124, 32, v124
  s_mov_b32 s58, s59
  s_mov_b32 s71, 3
  s_nop 0
  v_mfma_f32_32x32x8_bf16 v[48:63], v[110:111], v[110:111], 0
  s_waitcnt lgkmcnt(0)
  s_setprio 2
  s_cmp_eq_u32 s59, 0
  s_cbranch_scc1 L_out
  s_cmp_lg_u64 s[76:77], 0
  s_cbranch_scc1 L_gen0
L_bin0:
  s_cmp_ge_u32 s59, 5
  s_cbranch_scc1 L_w41
  s_cmp_gt_u32 s59, 1
  s_cbranch_scc1 L_w21
  s_waitcnt vmcnt(0)
L_w21:
  s_waitcnt vmcnt(2)
L_w41:
  s_waitcnt vmcnt(4)
L_aw1:
  ds_read_b128 v[92:95], v114 offset:0
  ds_read_b128 v[96:99], v115 offset:0
  ds_read_b64_tr_b16 v[100:101], v116 offset:0
  ds_read_b64_tr_b16 v[102:103], v117 offset:0
  ds_read_b64_tr_b16 v[104:105], v118 offset:0
  ds_read_b64_tr_b16 v[106:107], v119 offset:0
  s_cmp_ge_u32 s59, 6
  s_cbranch_scc0 L_i21
  ds_read_u8 v120, v124 offset:16
  ds_read_u8 v122, v124 offset:24
  s_branch L_i31
L_i21:
  ds_read_u8 v120, v124 offset:0
  ds_read_u8 v122, v124 offset:8
L_i31:
  s_cmp_gt_u32 s59, s40
  s_cbranch_scc1 L_p1
  s_setprio 1
  s_cmp_gt_u32 s59, s41
  s_cbranch_scc1 L_p1
  s_setprio 0
L_p1:
  s_waitcnt lgkmcnt(7)
  v_mfma_f32_16x16x32_bf16 v[76:79], v[0:3], v[92:95], v[32:35]
  v_mfma_f32_16x16x32_bf16 v[80:83], v[8:11], v[92:95], v[36:39]
  v_mfma_f32_16x16x32_bf16 v[84:87], v[16:19], v[92:95], v[40:43]
  v_mfma_f32_16x16x32_bf16 v[88:91], v[24:27], v[92:95], v[44:47]
  s_waitcnt lgkmcnt(6)
  v_mfma_f32_16x16x32_bf16 v[76:79], v[4:7], v[96:99], v[76:79]
  v_mfma_f32_16x16x32_bf16 v[80:83], v[12:15], v[96:99], v[80:83]
  v_mfma_f32_16x16x32_bf16 v[84:87], v[20:23], v[96:99], v[84:87]
  v_mfma_f32_16x16x32_bf16 v[88:91], v[28:31], v[96:99], v[88:91]
  s_nop 4
  v_exp_f32 v76, v76
  v_exp_f32 v77, v77
  v_exp_f32 v78, v78
  v_exp_f32 v79, v79
  v_exp_f32 v80, v80
  v_exp_f32 v81, v81
  v_exp_f32 v82, v82
  v_exp_f32 v83, v83
  v_exp_f32 v84, v84
  v_exp_f32 v85, v85
  v_exp_f32 v86, v86
  v_exp_f32 v87, v87
  v_exp_f32 v88, v88
  v_exp_f32 v89, v89
  v_exp_f32 v90, v90
  v_exp_f32 v91, v91
  s_nop 1
  v_mfma_f32_32x32x8_bf16 v[76:91], v[112:113], v[112:113], v[76:91]
  s_nop 11
  v_rcp_f32 v76, v76
  v_rcp_f32 v77, v77
  v_rcp_f32 v78, v78
  v_rcp_f32 v79, v79
  v_rcp_f32 v80, v80
  v_rcp_f32 v81, v81
  v_rcp_f32 v82, v82
  v_rcp_f32 v83, v83
  v_rcp_f32 v84, v84
  v_rcp_f32 v85, v85
  v_rcp_f32 v86, v86
  v_rcp_f32 v87, v87
  v_rcp_f32 v88, v88
  v_rcp_f32 v89, v89
  v_rcp_f32 v90, v90
  v_rcp_f32 v91, v91
  v_cvt_pk_bf16_f32 v92, v76, v77
  v_cvt_pk_bf16_f32 v93, v78, v79
  v_cvt_pk_bf16_f32 v94, v80, v81
  v_cvt_pk_bf16_f32 v95, v82, v83
  v_cvt_pk_bf16_f32 v96, v84, v85
  v_cvt_pk_bf16_f32 v97, v86, v87
  v_cvt_pk_bf16_f32 v98, v88, v89
  v_cvt_pk_bf16_f32 v99, v90, v91
  s_nop 0
  v_mfma_f32_16x16x32_bf16 v[108:111], v[92:95], v[64:67], v[72:75]
  v_mfma_f32_16x16x32_bf16 v[108:111], v[96:99], v[68:71], v[108:111]
  s_nop 7
  s_waitcnt lgkmcnt(0)
  v_cvt_pk_bf16_f32 v108, v108, v109
  v_cvt_pk_bf16_f32 v109, v110, v111
  s_cmp_gt_u32 s59, 5
  s_nop 0
  v_mfma_f32_16x16x16_bf16 v[48:51], v[108:109], v[100:101], v[48:51]
  v_mfma_f32_16x16x16_bf16 v[52:55], v[108:109], v[102:103], v[52:55]
  v_mfma_f32_16x16x16_bf16 v[56:59], v[108:109], v[104:105], v[56:59]
  v_mfma_f32_16x16x16_bf16 v[60:63], v[108:109], v[106:107], v[60:63]
  s_cbranch_scc0 L_h21
  s_add_u32 m0, s56, 0
  s_nop 0
  buffer_load_dwordx4 v[120:121], s[24:27], 0 idxen offen nt lds
  s_add_u32 m0, s56, 1024
  s_nop 0
  buffer_load_dwordx4 v[122:123], s[24:27], 0 idxen offen nt lds
  s_add_u32 s71, s71, 1
  s_branch L_nd1
L_h21:
  s_sub_u32 s74, s58, s59
  s_add_u32 s74, s74, 2
  s_cmp_eq_u32 s74, s71
  s_cbranch_scc0 L_nd1
  s_cmp_gt_u32 s59, 2
  s_cbranch_scc0 L_nd1
  s_add_u32 m0, s56, 4096
  s_add_u32 s71, s71, 1
  buffer_load_dwordx4 v[120:121], s[24:27], 0 idxen offen nt lds
  s_add_u32 m0, s56, 5120
  s_nop 0
  buffer_load_dwordx4 v[122:123], s[24:27], 0 idxen offen nt lds
L_nd1:
  s_sub_u32 s59, s59, 1
  s_cmp_eq_u32 s59, 0
  s_cbranch_scc1 L_out
  s_cmp_ge_u32 s59, 5
  s_cbranch_scc1 L_w42
  s_cmp_gt_u32 s59, 1
  s_cbranch_scc1 L_w22
  s_waitcnt vmcnt(0)
L_w22:
  s_waitcnt vmcnt(2)
L_w42:
  s_waitcnt vmcnt(4)
L_aw2:
  ds_read_b128 v[92:95], v114 offset:2048
  ds_read_b128 v[96:99], v115 offset:2048
  ds_read_b64_tr_b16 v[100:101], v116 offset:2048
  ds_read_b64_tr_b16 v[102:103], v117 offset:2048
  ds_read_b64_tr_b16 v[104:105], v118 offset:2048
  ds_read_b64_tr_b16 v[106:107], v119 offset:2048
  s_cmp_ge_u32 s59, 6
  s_cbranch_scc0 L_i22
  ds_read_u8 v120, v124 offset:32
  ds_read_u8 v122, v124 offset:40
  s_branch L_i32
L_i22:
  ds_read_u8 v120, v124 offset:16
  ds_read_u8 v122, v124 offset:24
L_i32:
  s_cmp_gt_u32 s59, s40
  s_cbranch_scc1 L_p2
  s_setprio 1
  s_cmp_gt_u32 s59, s41
  s_cbranch_scc1 L_p2
  s_setprio 0
L_p2:
  s_waitcnt lgkmcnt(7)
  v_mfma_f32_16x16x32_bf16 v[76:79], v[0:3], v[92:95], v[32:35]
  v_mfma_f32_16x16x32_bf16 v[80:83], v[8:11], v[92:95], v[36:39]
  v_mfma_f32_16x16x32_bf16 v[84:87], v[16:19], v[92:95], v[40:43]
  v_mfma_f32_16x16x32_bf16 v[88:91], v[24:27], v[92:95], v[44:47]
  s_waitcnt lgkmcnt(6)
  v_mfma_f32_16x16x32_bf16 v[76:79], v[4:7], v[96:99], v[76:79]
  v_mfma_f32_16x16x32_bf16 v[80:83], v[12:15], v[96:99], v[80:83]
  v_mfma_f32_16x16x32_bf16 v[84:87], v[20:23], v[96:99], v[84:87]
  v_mfma_f32_16x16x32_bf16 v[88:91], v[28:31], v[96:99], v[88:91]
  s_nop 4
  v_exp_f32 v76, v76
  v_exp_f32 v77, v77
  v_exp_f32 v78, v78
  v_exp_f32 v79, v79
  v_exp_f32 v80, v80
  v_exp_f32 v81, v81
  v_exp_f32 v82, v82
  v_exp_f32 v83, v83
  v_exp_f32 v84, v84
  v_exp_f32 v85, v85
  v_exp_f32 v86, v86
  v_exp_f32 v87, v87
  v_exp_f32 v88, v88
  v_exp_f32 v89, v89
  v_exp_f32 v90, v90
  v_exp_f32 v91, v91
  s_nop 1
  v_mfma_f32_32x32x8_bf16 v[76:91], v[112:113], v[112:113], v[76:91]
  s_nop 11
  v_rcp_f32 v76, v76
  v_rcp_f32 v77, v77
  v_rcp_f32 v78, v78
  v_rcp_f32 v79, v79
  v_rcp_f32 v80, v80
  v_rcp_f32 v81, v81
  v_rcp_f32 v82, v82
  v_rcp_f32 v83, v83
  v_rcp_f32 v84, v84
  v_rcp_f32 v85, v85
  v_rcp_f32 v86, v86
  v_rcp_f32 v87, v87
  v_rcp_f32 v88, v88
  v_rcp_f32 v89, v89
  v_rcp_f32 v90, v90
  v_rcp_f32 v91, v91
  v_cvt_pk_bf16_f32 v92, v76, v77
  v_cvt_pk_bf16_f32 v93, v78, v79
  v_cvt_pk_bf16_f32 v94, v80, v81
  v_cvt_pk_bf16_f32 v95, v82, v83
  v_cvt_pk_bf16_f32 v96, v84, v85
  v_cvt_pk_bf16_f32 v97, v86, v87
  v_cvt_pk_bf16_f32 v98, v88, v89
  v_cvt_pk_bf16_f32 v99, v90, v91
  s_nop 0
  v_mfma_f32_16x16x32_bf16 v[108:111], v[92:95], v[64:67], v[72:75]
  v_mfma_f32_16x16x32_bf16 v[108:111], v[96:99], v[68:71], v[108:111]
  s_nop 7
  s_waitcnt lgkmcnt(0)
  v_cvt_pk_bf16_f32 v108, v108, v109
  v_cvt_pk_bf16_f32 v109, v110, v111
  s_cmp_gt_u32 s59, 5
  s_nop 0
  v_mfma_f32_16x16x16_bf16 v[48:51], v[108:109], v[100:101], v[48:51]
  v_mfma_f32_16x16x16_bf16 v[52:55], v[108:109], v[102:103], v[52:55]
  v_mfma_f32_16x16x16_bf16 v[56:59], v[108:109], v[104:105], v[56:59]
  v_mfma_f32_16x16x16_bf16 v[60:63], v[108:109], v[106:107], v[60:63]
  s_cbranch_scc0 L_h22
  s_add_u32 m0, s56, 2048
  s_nop 0
  buffer_load_dwordx4 v[120:121], s[24:27], 0 idxen offen nt lds
  s_add_u32 m0, s56, 3072
  s_nop 0
  buffer_load_dwordx4 v[122:123], s[24:27], 0 idxen offen nt lds
  s_add_u32 s71, s71, 1
  s_branch L_nd2
L_h22:
  s_sub_u32 s74, s58, s59
  s_add_u32 s74, s74, 2
  s_cmp_eq_u32 s74, s71
  s_cbranch_scc0 L_nd2
  s_cmp_gt_u32 s59, 2
  s_cbranch_scc0 L_nd2
  s_add_u32 m0, s56, 0
  s_add_u32 s71, s71, 1
  buffer_load_dwordx4 v[120:121], s[24:27], 0 idxen offen nt lds
  s_add_u32 m0, s56, 1024
  s_nop 0
  buffer_load_dwordx4 v[122:123], s[24:27], 0 idxen offen nt lds
L_nd2:
  s_sub_u32 s59, s59, 1
  s_cmp_eq_u32 s59, 0
  s_cbranch_scc1 L_out
  s_cmp_ge_u32 s59, 5
  s_cbranch_scc1 L_w43
  s_cmp_gt_u32 s59, 1
  s_cbranch_scc1 L_w23
  s_waitcnt vmcnt(0)
L_w23:
  s_waitcnt vmcnt(2)
L_w43:
  s_waitcnt vmcnt(4)
L_aw3:
  ds_read_b128 v[92:95], v114 offset:4096
  ds_read_b128 v[96:99], v115 offset:4096
  ds_read_b64_tr_b16 v[100:101], v116 offset:4096
  ds_read_b64_tr_b16 v[102:103], v117 offset:4096
  ds_read_b64_tr_b16 v[104:105], v118 offset:4096
  ds_read_b64_tr_b16 v[106:107], v119 offset:4096
  s_cmp_ge_u32 s59, 6
  s_cbranch_scc0 L_i23
  ds_read_u8 v120, v124 offset:48
  ds_read_u8 v122, v124 offset:56
  s_branch L_i33
L_i23:
  ds_read_u8 v120, v124 offset:32
  ds_read_u8 v122, v124 offset:40
L_i33:
  s_cmp_gt_u32 s59, s40
  s_cbranch_scc1 L_p3
  s_setprio 1
  s_cmp_gt_u32 s59, s41
  s_cbranch_scc1 L_p3
  s_setprio 0
L_p3:
  s_waitcnt lgkmcnt(7)
  v_mfma_f32_16x16x32_bf16 v[76:79], v[0:3], v[92:95], v[32:35]
  v_mfma_f32_16x16x32_bf16 v[80:83], v[8:11], v[92:95], v[36:39]
  v_mfma_f32_16x16x32_bf16 v[84:87], v[16:19], v[92:95], v[40:43]
  v_mfma_f32_16x16x32_bf16 v[88:91], v[24:27], v[92:95], v[44:47]
  s_waitcnt lgkmcnt(6)
  v_mfma_f32_16x16x32_bf16 v[76:79], v[4:7], v[96:99], v[76:79]
  v_mfma_f32_16x16x32_bf16 v[80:83], v[12:15], v[96:99], v[80:83]
  v_mfma_f32_16x16x32_bf16 v[84:87], v[20:23], v[96:99], v[84:87]
  v_mfma_f32_16x16x32_bf16 v[88:91], v[28:31], v[96:99], v[88:91]
  s_nop 4
  v_exp_f32 v76, v76
  v_exp_f32 v77, v77
  v_exp_f32 v78, v78
  v_exp_f32 v79, v79
  v_exp_f32 v80, v80
  v_exp_f32 v81, v81
  v_exp_f32 v82, v82
  v_exp_f32 v83, v83
  v_exp_f32 v84, v84
  v_exp_f32 v85, v85
  v_exp_f32 v86, v86
  v_exp_f32 v87, v87
  v_exp_f32 v88, v88
  v_exp_f32 v89, v89
  v_exp_f32 v90, v90
  v_exp_f32 v91, v91
  s_nop 1
  v_mfma_f32_32x32x8_bf16 v[76:91], v[112:113], v[112:113], v[76:91]
  s_nop 11
  v_rcp_f32 v76, v76
  v_rcp_f32 v77, v77
  v_rcp_f32 v78, v78
  v_rcp_f32 v79, v79
  v_rcp_f32 v80, v80
  v_rcp_f32 v81, v81
  v_rcp_f32 v82, v82
  v_rcp_f32 v83, v83
  v_rcp_f32 v84, v84
  v_rcp_f32 v85, v85
  v_rcp_f32 v86, v86
  v_rcp_f32 v87, v87
  v_rcp_f32 v88, v88
  v_rcp_f32 v89, v89
  v_rcp_f32 v90, v90
  v_rcp_f32 v91, v91
  v_cvt_pk_bf16_f32 v92, v76, v77
  v_cvt_pk_bf16_f32 v93, v78, v79
  v_cvt_pk_bf16_f32 v94, v80, v81
  v_cvt_pk_bf16_f32 v95, v82, v83
  v_cvt_pk_bf16_f32 v96, v84, v85
  v_cvt_pk_bf16_f32 v97, v86, v87
  v_cvt_pk_bf16_f32 v98, v88, v89
  v_cvt_pk_bf16_f32 v99, v90, v91
  s_nop 0
  v_mfma_f32_16x16x32_bf16 v[108:111], v[92:95], v[64:67], v[72:75]
  v_mfma_f32_16x16x32_bf16 v[108:111], v[96:99], v[68:71], v[108:111]
  s_nop 7
  s_waitcnt lgkmcnt(0)
  v_cvt_pk_bf16_f32 v108, v108, v109
  v_cvt_pk_bf16_f32 v109, v110, v111
  s_cmp_gt_u32 s59, 5
  s_nop 0
  v_mfma_f32_16x16x16_bf16 v[48:51], v[108:109], v[100:101], v[48:51]
  v_mfma_f32_16x16x16_bf16 v[52:55], v[108:109], v[102:103], v[52:55]
  v_mfma_f32_16x16x16_bf16 v[56:59], v[108:109], v[104:105], v[56:59]
  v_mfma_f32_16x16x16_bf16 v[60:63], v[108:109], v[106:107], v[60:63]
  s_cbranch_scc0 L_h23
  s_add_u32 m0, s56, 4096
  s_nop 0
  buffer_load_dwordx4 v[120:121], s[24:27], 0 idxen offen nt lds
  s_add_u32 m0, s56, 5120
  s_nop 0
  buffer_load_dwordx4 v[122:123], s[24:27], 0 idxen offen nt lds
  s_add_u32 s71, s71, 1
  s_branch L_nd3
L_h23:
  s_sub_u32 s74, s58, s59
  s_add_u32 s74, s74, 2
  s_cmp_eq_u32 s74, s71
  s_cbranch_scc0 L_nd3
  s_cmp_gt_u32 s59, 2
  s_cbranch_scc0 L_nd3
  s_add_u32 m0, s56, 2048
  s_add_u32 s71, s71, 1
  buffer_load_dwordx4 v[120:121], s[24:27], 0 idxen offen nt lds
  s_add_u32 m0, s56, 3072
  s_nop 0
  buffer_load_dwordx4 v[122:123], s[24:27], 0 idxen offen nt lds
L_nd3:
  v_add_u32 v124, 48, v124
  s_sub_u32 s59, s59, 1
  s_cmp_eq_u32 s59, 0
  s_cbranch_scc1 L_out
  s_branch L_bin0
L_gen0:
  s_cmp_ge_u32 s59, 5
  s_cbranch_scc1 L_w44
  s_cmp_gt_u32 s59, 1
  s_cbranch_scc1 L_w24
  s_waitcnt vmcnt(0)
L_w24:
  s_waitcnt vmcnt(2)
L_w44:
  s_waitcnt vmcnt(4)
L_aw4:
  ds_read_b128 v[92:95], v114 offset:0
  ds_read_b128 v[96:99], v115 offset:0
  ds_read_b64_tr_b16 v[100:101], v116 offset:0
  ds_read_b64_tr_b16 v[102:103], v117 offset:0
  ds_read_b64_tr_b16 v[104:105], v118 offset:0
  ds_read_b64_tr_b16 v[106:107], v119 offset:0
  s_cmp_ge_u32 s59, 6
  s_cbranch_scc0 L_i24
  ds_read_u8 v120, v124 offset:16
  ds_read_u8 v122, v124 offset:24
  s_branch L_i34
L_i24:
  ds_read_u8 v120, v124 offset:0
  ds_read_u8 v122, v124 offset:8
L_i34:
  s_cmp_gt_u32 s59, s40
  s_cbranch_scc1 L_p4
  s_setprio 1
  s_cmp_gt_u32 s59, s41
  s_cbranch_scc1 L_p4
  s_setprio 0
L_p4:
  s_waitcnt lgkmcnt(7)
  v_mfma_f32_16x16x32_bf16 v[76:79], v[0:3], v[92:95], v[32:35]
  v_mfma_f32_16x16x32_bf16 v[80:83], v[8:11], v[92:95], v[36:39]
  v_mfma_f32_16x16x32_bf16 v[84:87], v[16:19], v[92:95], v[40:43]
  v_mfma_f32_16x16x32_bf16 v[88:91], v[24:27], v[92:95], v[44:47]
  s_waitcnt lgkmcnt(6)
  v_mfma_f32_16x16x32_bf16 v[76:79], v[4:7], v[96:99], v[76:79]
  v_mfma_f32_16x16x32_bf16 v[80:83], v[12:15], v[96:99], v[80:83]
  v_mfma_f32_16x16x32_bf16 v[84:87], v[20:23], v[96:99], v[84:87]
  v_mfma_f32_16x16x32_bf16 v[88:91], v[28:31], v[96:99], v[88:91]
  s_nop 4
  v_exp_f32 v76, v76
  v_exp_f32 v77, v77
  v_exp_f32 v78, v78
  v_exp_f32 v79, v79
  v_exp_f32 v80, v80
  v_exp_f32 v81, v81
  v_exp_f32 v82, v82
  v_exp_f32 v83, v83
  v_exp_f32 v84, v84
  v_exp_f32 v85, v85
  v_exp_f32 v86, v86
  v_exp_f32 v87, v87
  v_exp_f32 v88, v88
  v_exp_f32 v89, v89
  v_exp_f32 v90, v90
  v_exp_f32 v91, v91
  s_nop 1
  v_mfma_f32_32x32x8_bf16 v[76:91], v[112:113], v[112:113], v[76:91]
  s_nop 11
  v_rcp_f32 v76, v76
  v_rcp_f32 v77, v77
  v_rcp_f32 v78, v78
  v_rcp_f32 v79, v79
  v_rcp_f32 v80, v80
  v_rcp_f32 v81, v81
  v_rcp_f32 v82, v82
  v_rcp_f32 v83, v83
  v_rcp_f32 v84, v84
  v_rcp_f32 v85, v85
  v_rcp_f32 v86, v86
  v_rcp_f32 v87, v87
  v_rcp_f32 v88, v88
  v_rcp_f32 v89, v89
  v_rcp_f32 v90, v90
  v_rcp_f32 v91, v91
  v_cvt_pk_bf16_f32 v92, v76, v77
  v_cvt_pk_bf16_f32 v93, v78, v79
  v_cvt_pk_bf16_f32 v94, v80, v81
  v_cvt_pk_bf16_f32 v95, v82, v83
  v_cvt_pk_bf16_f32 v96, v84, v85
  v_cvt_pk_bf16_f32 v97, v86, v87
  v_cvt_pk_bf16_f32 v98, v88, v89
  v_cvt_pk_bf16_f32 v99, v90, v91
  ds_read_b128 v[76:79], v125 offset:0
  v_mfma_f32_16x16x32_bf16 v[108:111], v[92:95], v[64:67], v[72:75]
  v_mfma_f32_16x16x32_bf16 v[108:111], v[96:99], v[68:71], v[108:111]
  s_nop 7
  s_waitcnt lgkmcnt(0)
  v_mul_f32 v108, v76, v108
  v_mul_f32 v109, v77, v109
  v_mul_f32 v110, v78, v110
  v_mul_f32 v111, v79, v111
  v_cvt_pk_bf16_f32 v108, v108, v109
  v_cvt_pk_bf16_f32 v109, v110, v111
  s_cmp_gt_u32 s59, 5
  s_nop 0
  v_mfma_f32_16x16x16_bf16 v[48:51], v[108:109], v[100:101], v[48:51]
  v_mfma_f32_16x16x16_bf16 v[52:55], v[108:109], v[102:103], v[52:55]
  v_mfma_f32_16x16x16_bf16 v[56:59], v[108:109], v[104:105], v[56:59]
  v_mfma_f32_16x16x16_bf16 v[60:63], v[108:109], v[106:107], v[60:63]
  s_cbranch_scc0 L_h24
  s_add_u32 m0, s56, 0
  s_nop 0
  buffer_load_dwordx4 v[120:121], s[24:27], 0 idxen offen nt lds
  s_add_u32 m0, s56, 1024
  s_nop 0
  buffer_load_dwordx4 v[122:123], s[24:27], 0 idxen offen nt lds
  s_add_u32 s71, s71, 1
  s_branch L_nd4
L_h24:
  s_sub_u32 s74, s58, s59
  s_add_u32 s74, s74, 2
  s_cmp_eq_u32 s74, s71
  s_cbranch_scc0 L_nd4
  s_cmp_gt_u32 s59, 2
  s_cbranch_scc0 L_nd4
  s_add_u32 m0, s56, 4096
  s_add_u32 s71, s71, 1
  buffer_load_dwordx4 v[120:121], s[24:27], 0 idxen offen nt lds
  s_add_u32 m0, s56, 5120
  s_nop 0
  buffer_load_dwordx4 v[122:123], s[24:27], 0 idxen offen nt lds
L_nd4:
  s_sub_u32 s59, s59, 1
  s_cmp_eq_u32 s59, 0
  s_cbranch_scc1 L_out
  s_cmp_ge_u32 s59, 5
  s_cbranch_scc1 L_w45
  s_cmp_gt_u32 s59, 1
  s_cbranch_scc1 L_w25
  s_waitcnt vmcnt(0)
L_w25:
  s_waitcnt vmcnt(2)
L_w45:
  s_waitcnt vmcnt(4)
L_aw5:
  ds_read_b128 v[92:95], v114 offset:2048
  ds_read_b128 v[96:99], v115 offset:2048
  ds_read_b64_tr_b16 v[100:101], v116 offset:2048
  ds_read_b64_tr_b16 v[102:103], v117 offset:2048
  ds_read_b64_tr_b16 v[104:105], v118 offset:2048
  ds_read_b64_tr_b16 v[106:107], v119 offset:2048
  s_cmp_ge_u32 s59, 6
  s_cbranch_scc0 L_i25
  ds_read_u8 v120, v124 offset:32
  ds_read_u8 v122, v124 offset:40
  s_branch L_i35
L_i25:
  ds_read_u8 v120, v124 offset:16
  ds_read_u8 v122, v124 offset:24
L_i35:
  s_cmp_gt_u32 s59, s40
  s_cbranch_scc1 L_p5
  s_setprio 1
  s_cmp_gt_u32 s59, s41
  s_cbranch_scc1 L_p5
  s_setprio 0
L_p5:
  s_waitcnt lgkmcnt(7)
  v_mfma_f32_16x16x32_bf16 v[76:79], v[0:3], v[92:95], v[32:35]
  v_mfma_f32_16x16x32_bf16 v[80:83], v[8:11], v[92:95], v[36:39]
  v_mfma_f32_16x16x32_bf16 v[84:87], v[16:19], v[92:95], v[40:43]
  v_mfma_f32_16x16x32_bf16 v[88:91], v[24:27], v[92:95], v[44:47]
  s_waitcnt lgkmcnt(6)
  v_mfma_f32_16x16x32_bf16 v[76:79], v[4:7], v[96:99], v[76:79]
  v_mfma_f32_16x16x32_bf16 v[80:83], v[12:15], v[96:99], v[80:83]
  v_mfma_f32_16x16x32_bf16 v[84:87], v[20:23], v[96:99], v[84:87]
  v_mfma_f32_16x16x32_bf16 v[88:91], v[28:31], v[96:99], v[88:91]
  s_nop 4
  v_exp_f32 v76, v76
  v_exp_f32 v77, v77
  v_exp_f32 v78, v78
  v_exp_f32 v79, v79
  v_exp_f32 v80, v80
  v_exp_f32 v81, v81
  v_exp_f32 v82, v82
  v_exp_f32 v83, v83
  v_exp_f32 v84, v84
  v_exp_f32 v85, v85
  v_exp_f32 v86, v86
  v_exp_f32 v87, v87
  v_exp_f32 v88, v88
  v_exp_f32 v89, v89
  v_exp_f32 v90, v90
  v_exp_f32 v91, v91
  s_nop 1
  v_mfma_f32_32x32x8_bf16 v[76:91], v[112:113], v[112:113], v[76:91]
  s_nop 11
  v_rcp_f32 v76, v76
  v_rcp_f32 v77, v77
  v_rcp_f32 v78, v78
  v_rcp_f32 v79, v79
  v_rcp_f32 v80, v80
  v_rcp_f32 v81, v81
  v_rcp_f32 v82, v82
  v_rcp_f32 v83, v83
  v_rcp_f32 v84, v84
  v_rcp_f32 v85, v85
  v_rcp_f32 v86, v86
  v_rcp_f32 v87, v87
  v_rcp_f32 v88, v88
  v_rcp_f32 v89, v89
  v_rcp_f32 v90, v90
  v_rcp_f32 v91, v91
  v_cvt_pk_bf16_f32 v92, v76, v77
  v_cvt_pk_bf16_f32 v93, v78, v79
  v_cvt_pk_bf16_f32 v94, v80, v81
  v_cvt_pk_bf16_f32 v95, v82, v83
  v_cvt_pk_bf16_f32 v96, v84, v85
  v_cvt_pk_bf16_f32 v97, v86, v87
  v_cvt_pk_bf16_f32 v98, v88, v89
  v_cvt_pk_bf16_f32 v99, v90, v91
  ds_read_b128 v[76:79], v125 offset:64
  v_mfma_f32_16x16x32_bf16 v[108:111], v[92:95], v[64:67], v[72:75]
  v_mfma_f32_16x16x32_bf16 v[108:111], v[96:99], v[68:71], v[108:111]
  s_nop 7
  s_waitcnt lgkmcnt(0)
  v_mul_f32 v108, v76, v108
  v_mul_f32 v109, v77, v109
  v_mul_f32 v110, v78, v110
  v_mul_f32 v111, v79, v111
  v_cvt_pk_bf16_f32 v108, v108, v109
  v_cvt_pk_bf16_f32 v109, v110, v111
  s_cmp_gt_u32 s59, 5
  s_nop 0
  v_mfma_f32_16x16x16_bf16 v[48:51], v[108:109], v[100:101], v[48:51]
  v_mfma_f32_16x16x16_bf16 v[52:55], v[108:109], v[102:103], v[52:55]
  v_mfma_f32_16x16x16_bf16 v[56:59], v[108:109], v[104:105], v[56:59]
  v_mfma_f32_16x16x16_bf16 v[60:63], v[108:109], v[106:107], v[60:63]
  s_cbranch_scc0 L_h25
  s_add_u32 m0, s56, 2048
  s_nop 0
  buffer_load_dwordx4 v[120:121], s[24:27], 0 idxen offen nt lds
  s_add_u32 m0, s56, 3072
  s_nop 0
  buffer_load_dwordx4 v[122:123], s[24:27], 0 idxen offen nt lds
  s_add_u32 s71, s71, 1
  s_branch L_nd5
L_h25:
  s_sub_u32 s74, s58, s59
  s_add_u32 s74, s74, 2
  s_cmp_eq_u32 s74, s71
  s_cbranch_scc0 L_nd5
  s_cmp_gt_u32 s59, 2
  s_cbranch_scc0 L_nd5
  s_add_u32 m0, s56, 0
  s_add_u32 s71, s71, 1
  buffer_load_dwordx4 v[120:121], s[24:27], 0 idxen offen nt lds
  s_add_u32 m0, s56, 1024
  s_nop 0
  buffer_load_dwordx4 v[122:123], s[24:27], 0 idxen offen nt lds
L_nd5:
  s_sub_u32 s59, s59, 1
  s_cmp_eq_u32 s59, 0
  s_cbranch_scc1 L_out
  s_cmp_ge_u32 s59, 5
  s_cbranch_scc1 L_w46
  s_cmp_gt_u32 s59, 1
  s_cbranch_scc1 L_w26
  s_waitcnt vmcnt(0)
L_w26:
  s_waitcnt vmcnt(2)
L_w46:
  s_waitcnt vmcnt(4)
L_aw6:
  ds_read_b128 v[92:95], v114 offset:4096
  ds_read_b128 v[96:99], v115 offset:4096
  ds_read_b64_tr_b16 v[100:101], v116 offset:4096
  ds_read_b64_tr_b16 v[102:103], v117 offset:4096
  ds_read_b64_tr_b16 v[104:105], v118 offset:4096
  ds_read_b64_tr_b16 v[106:107], v119 offset:4096
  s_cmp_ge_u32 s59, 6
  s_cbranch_scc0 L_i26
  ds_read_u8 v120, v124 offset:48
  ds_read_u8 v122, v124 offset:56
  s_branch L_i36
L_i26:
  ds_read_u8 v120, v124 offset:32
  ds_read_u8 v122, v124 offset:40
L_i36:
  s_cmp_gt_u32 s59, s40
  s_cbranch_scc1 L_p6
  s_setprio 1
  s_cmp_gt_u32 s59, s41
  s_cbranch_scc1 L_p6
  s_setprio 0
L_p6:
  s_waitcnt lgkmcnt(7)
  v_mfma_f32_16x16x32_bf16 v[76:79], v[0:3], v[92:95], v[32:35]
  v_mfma_f32_16x16x32_bf16 v[80:83], v[8:11], v[92:95], v[36:39]
  v_mfma_f32_16x16x32_bf16 v[84:87], v[16:19], v[92:95], v[40:43]
  v_mfma_f32_16x16x32_bf16 v[88:91], v[24:27], v[92:95], v[44:47]
  s_waitcnt lgkmcnt(6)
  v_mfma_f32_16x16x32_bf16 v[76:79], v[4:7], v[96:99], v[76:79]
  v_mfma_f32_16x16x32_bf16 v[80:83], v[12:15], v[96:99], v[80:83]
  v_mfma_f32_16x16x32_bf16 v[84:87], v[20:23], v[96:99], v[84:87]
  v_mfma_f32_16x16x32_bf16 v[88:91], v[28:31], v[96:99], v[88:91]
  s_nop 4
  v_exp_f32 v76, v76
  v_exp_f32 v77, v77
  v_exp_f32 v78, v78
  v_exp_f32 v79, v79
  v_exp_f32 v80, v80
  v_exp_f32 v81, v81
  v_exp_f32 v82, v82
  v_exp_f32 v83, v83
  v_exp_f32 v84, v84
  v_exp_f32 v85, v85
  v_exp_f32 v86, v86
  v_exp_f32 v87, v87
  v_exp_f32 v88, v88
  v_exp_f32 v89, v89
  v_exp_f32 v90, v90
  v_exp_f32 v91, v91
  s_nop 1
  v_mfma_f32_32x32x8_bf16 v[76:91], v[112:113], v[112:113], v[76:91]
  s_nop 11
  v_rcp_f32 v76, v76
  v_rcp_f32 v77, v77
  v_rcp_f32 v78, v78
  v_rcp_f32 v79, v79
  v_rcp_f32 v80, v80
  v_rcp_f32 v81, v81
  v_rcp_f32 v82, v82
  v_rcp_f32 v83, v83
  v_rcp_f32 v84, v84
  v_rcp_f32 v85, v85
  v_rcp_f32 v86, v86
  v_rcp_f32 v87, v87
  v_rcp_f32 v88, v88
  v_rcp_f32 v89, v89
  v_rcp_f32 v90, v90
  v_rcp_f32 v91, v91
  v_cvt_pk_bf16_f32 v92, v76, v77
  v_cvt_pk_bf16_f32 v93, v78, v79
  v_cvt_pk_bf16_f32 v94, v80, v81
  v_cvt_pk_bf16_f32 v95, v82, v83
  v_cvt_pk_bf16_f32 v96, v84, v85
  v_cvt_pk_bf16_f32 v97, v86, v87
  v_cvt_pk_bf16_f32 v98, v88, v89
  v_cvt_pk_bf16_f32 v99, v90, v91
  ds_read_b128 v[76:79], v125 offset:128
  v_mfma_f32_16x16x32_bf16 v[108:111], v[92:95], v[64:67], v[72:75]
  v_mfma_f32_16x16x32_bf16 v[108:111], v[96:99], v[68:71], v[108:111]
  v_add_u32 v125, 192, v125
  s_nop 7
  s_waitcnt lgkmcnt(0)
  v_mul_f32 v108, v76, v108
  v_mul_f32 v109, v77, v109
  v_mul_f32 v110, v78, v110
  v_mul_f32 v111, v79, v111
  v_cvt_pk_bf16_f32 v108, v108, v109
  v_cvt_pk_bf16_f32 v109, v110, v111
  s_cmp_gt_u32 s59, 5
  s_nop 0
  v_mfma_f32_16x16x16_bf16 v[48:51], v[108:109], v[100:101], v[48:51]
  v_mfma_f32_16x16x16_bf16 v[52:55], v[108:109], v[102:103], v[52:55]
  v_mfma_f32_16x16x16_bf16 v[56:59], v[108:109], v[104:105], v[56:59]
  v_mfma_f32_16x16x16_bf16 v[60:63], v[108:109], v[106:107], v[60:63]
  s_cbranch_scc0 L_h26
  s_add_u32 m0, s56, 4096
  s_nop 0
  buffer_load_dwordx4 v[120:121], s[24:27], 0 idxen offen nt lds
  s_add_u32 m0, s56, 5120
  s_nop 0
  buffer_load_dwordx4 v[122:123], s[24:27], 0 idxen offen nt lds
  s_add_u32 s71, s71, 1
  s_branch L_nd6
L_h26:
  s_sub_u32 s74, s58, s59
  s_add_u32 s74, s74, 2
  s_cmp_eq_u32 s74, s71
  s_cbranch_scc0 L_nd6
  s_cmp_gt_u32 s59, 2
  s_cbranch_scc0 L_nd6
  s_add_u32 m0, s56, 2048
  s_add_u32 s71, s71, 1
  buffer_load_dwordx4 v[120:121], s[24:27], 0 idxen offen nt lds
  s_add_u32 m0, s56, 3072
  s_nop 0
  buffer_load_dwordx4 v[122:123], s[24:27], 0 idxen offen nt lds
L_nd6:
  v_add_u32 v124, 48, v124
  s_sub_u32 s59, s59, 1
  s_cmp_eq_u32 s59, 0
  s_cbranch_scc1 L_out
  s_branch L_gen0
L_out:
  s_nop 7
  v_lshl_add_u32 v76, v126, 1, s94
  v_cndmask_b32_e64 v77, v48, v52, s[60:61]
  v_cndmask_b32_e64 v77, v77, v56, s[62:63]
  v_cndmask_b32_e64 v77, v77, v60, s[64:65]
  v_cvt_pk_bf16_f32 v77, v77, v77
  global_store_short v76, v77, s[18:19]
  s_waitcnt vmcnt(0)
L_end:
  s_endpgm
L_genmask:
  s_add_u32 s74, s56, 6144
  v_mov_b32 v0, 0
  v_mov_b32 v1, 0
  v_mov_b32 v2, 0
  v_mov_b32 v3, 0
  v_lshl_add_u32 v82, v126, 4, s74
  ds_write_b128 v82, v[0:3]
  v_add_u32 v125, s74, v127
  v_lshlrev_b32 v4, 16, v64
  v_and_b32 v5, s70, v64
  v_lshlrev_b32 v6, 16, v65
  v_and_b32 v7, s70, v65
  v_subrev_u32 v78, s57, v78
  v_lshl_add_u32 v78, v78, 2, s74
  v_subrev_u32 v79, s57, v79
  v_lshl_add_u32 v79, v79, 2, s74
  v_subrev_u32 v80, s57, v80
  v_lshl_add_u32 v80, v80, 2, s74
  v_subrev_u32 v81, s57, v81
  v_lshl_add_u32 v81, v81, 2, s74
  s_mov_b64 exec, s[60:61]
  ds_write_b32 v78, v4
  s_mov_b64 exec, s[62:63]
  ds_write_b32 v79, v5
  s_mov_b64 exec, s[64:65]
  ds_write_b32 v80, v6
  s_mov_b64 exec, s[66:67]
  ds_write_b32 v81, v7
  s_mov_b64 exec, -1
  s_branch L_binmask
.section .rodata,"a"
.p2align 6
.amdhsa_kernel standalone__sequential_behavior_din__recsys_kernel
  .amdhsa_next_free_vgpr 128
  .amdhsa_next_free_sgpr 96
  .amdhsa_accum_offset 128
  .amdhsa_group_segment_fixed_size 0
  .amdhsa_kernarg_size 80
  .amdhsa_user_sgpr_count 2
  .amdhsa_user_sgpr_kernarg_segment_ptr 1
  .amdhsa_system_sgpr_workgroup_id_x 1
  .amdhsa_float_denorm_mode_32 3
.end_amdhsa_kernel
```
